```python
import torch

def _softmax(x, axis=-1):
    return torch.softmax(x, dim=axis)
def _gelu(x):
    return torch.nn.functional.gelu(x, approximate="tanh")
def _silu(x):
    return torch.nn.functional.silu(x)
def _sigmoid(x):
    return torch.sigmoid(x)
def _layernorm(x, axis=-1, eps=1e-5):
    m = x.mean(dim=axis, keepdim=True)
    v = x.var(dim=axis, keepdim=True, unbiased=False)
    return (x - m) / torch.sqrt(v + eps)
def _scatter_add(tgt, idx, src, axis=0):
    return tgt.clone().index_add_(axis, idx, src)
def _segment_sum(src, seg, n):
    out = torch.zeros((n,) + src.shape[1:], dtype=src.dtype)
    return out.index_add_(0, seg, src)
def _pad(x, pw):
    flat = tuple(v for pair in reversed(pw) for v in pair)
    return torch.nn.functional.pad(x, flat)

kernel_name = 'standalone__mha_softmax__sampling'

def setup_inputs():

    _w = (lambda a: (lambda t: t.to(torch.bfloat16) if t.is_floating_point() else t)(torch.as_tensor(a)))
    B, H, Sq, Sk, D = 8, 32, 4, 2048, 192
    return {
        "q": _w((lambda *s: torch.randn(*s, dtype=torch.bfloat16) * 0.8)(B, H, Sq, D)),
        "k": _w((lambda *s: torch.randn(*s, dtype=torch.bfloat16) * 0.8)(B, H, Sk, D)),
        "v": _w((lambda *s: torch.randn(*s, dtype=torch.bfloat16) * 0.05)(B, H, Sk, D)),
    }

def reference(q, k, v):
    scale = q.shape[-1] ** -0.5
    scores = torch.einsum("bhqd,bhkd->bhqk", q, k) * scale
    p = _softmax(scores, axis=-1)
    return torch.einsum("bhqk,bhkd->bhqd", p, v)
```

```asm
; @launch grid=(256,1,1) block=(256,1,1) lds=45440
.amdgcn_target "amdgcn-amd-amdhsa--gfx950"
.text
.globl standalone__mha_softmax__sampling_kernel
.p2align 8
.type standalone__mha_softmax__sampling_kernel,@function
standalone__mha_softmax__sampling_kernel:
  s_load_dwordx2 s[20:21], s[0:1], 0
  s_load_dwordx2 s[12:13], s[0:1], 8
  s_cmpk_ge_u32 s2, 256
  s_cbranch_scc1 L_end
  v_lshrrev_b32 v14, 3, v0
  v_and_b32 v14, 6, v14
  v_and_or_b32 v15, v0, 1, v14
  v_bfe_u32 v11, v0, 1, 1
  v_lshrrev_b32 v12, 5, v0
  v_and_or_b32 v11, v12, 6, v11
  v_and_b32 v12, 12, v0
  v_lshl_or_b32 v11, v12, 2, v11
  v_mad_u32_u24 v2, v11, 24, v15
  v_lshlrev_b32 v2, 4, v2
  v_bfe_u32 v12, v0, 2, 1
  v_or_b32 v12, v12, v14
  v_and_b32 v11, 3, v0
  v_mad_u32_u24 v13, v11, 24, v12
  v_lshlrev_b32 v13, 4, v13
  s_mov_b32 s14, 201326592
  s_mov_b32 s15, 0x20000
  s_mov_b32 s22, 393216
  s_mov_b32 s23, s15
  s_sub_u32 s28, 0, s2
  s_and_b32 s28, s28, 7
  s_lshl3_add_u32 s28, s2, s28
  s_mul_i32 s28, s28, 98304
  s_mul_i32 s33, s2, 1536
  s_waitcnt lgkmcnt(0)
  buffer_load_dwordx4 v[60:63], v13, s[20:23], s33 offen offset:0
  buffer_load_dwordx4 v[64:67], v13, s[20:23], s33 offen offset:128
  buffer_load_dwordx4 v[68:71], v13, s[20:23], s33 offen offset:256
  buffer_load_dwordx4 v[72:75], v2, s[12:15], s28 offen offset:0 nt
  buffer_load_dwordx4 v[76:79], v2, s[12:15], s28 offen offset:128 nt
  buffer_load_dwordx4 v[80:83], v2, s[12:15], s28 offen offset:256 nt
  s_load_dwordx4 s[16:19], s[0:1], 16
  v_lshrrev_b32 v14, 6, v0
  v_and_b32 v1, 63, v0
  v_readfirstlane_b32 s3, v14
  v_add_u32 v3, 128, v2
  v_add_u32 v4, 256, v2
  s_add_u32 s31, s2, 1
  s_mul_i32 s31, s31, 786432
  s_mov_b32 s26, 393216
  s_mov_b32 s27, 0x20000
  s_mov_b32 s30, 0x3dd53b95
  v_mul_u32_u24 v12, 768, v14
  v_and_b32 v14, 15, v1
  v_lshrrev_b32 v15, 4, v1
  buffer_load_dwordx4 v[84:87], v2, s[12:15], s28 offen offset:3072 nt
  buffer_load_dwordx4 v[88:91], v2, s[12:15], s28 offen offset:3200 nt
  buffer_load_dwordx4 v[92:95], v2, s[12:15], s28 offen offset:3328 nt
  s_add_u32 s28, s28, 24576
  v_lshl_add_u32 v10, v15, 2, v11
  v_lshlrev_b32 v10, 3, v10
  s_mul_i32 s34, s3, 8192
  s_add_u32 s34, s34, 12416
  v_add_u32 v10, s34, v10
  v_mul_u32_u24 v28, 6144, v15
  v_add_u32 v28, v28, v12
  v_lshrrev_b32 v11, 3, v14
  v_mul_u32_u24 v11, 384, v11
  v_add_u32 v30, v11, v28
  v_and_b32 v11, 7, v14
  v_lshl_add_u32 v30, v11, 4, v30
  v_add_u32 v30, 256, v30
  v_lshl_add_u32 v28, v14, 4, v28
  v_add_u32 v29, 384, v28
  v_bfe_u32 v11, v1, 2, 2
  v_mov_b32 v14, 0xffff
  v_mov_b32 v15, 0xffff0000
  v_mov_b32 v5, 0
  v_mov_b32 v6, 0
  v_cmp_eq_u32 vcc, 0, v11
  s_nop 1
  v_cndmask_b32 v5, v5, v14, vcc
  v_cmp_eq_u32 vcc, 1, v11
  s_nop 1
  v_cndmask_b32 v5, v5, v15, vcc
  v_cmp_eq_u32 vcc, 2, v11
  s_nop 1
  v_cndmask_b32 v6, v6, v14, vcc
  v_cmp_eq_u32 vcc, 3, v11
  s_nop 1
  v_cndmask_b32 v6, v6, v15, vcc
  v_lshl_add_u32 v31, v11, 7, v10
  v_mov_b32 v7, 0xff800000
  s_waitcnt lgkmcnt(0)
  s_mov_b32 s24, s18
  s_mov_b32 s25, s19
  s_mov_b32 s29, 16
L_loop:
  s_waitcnt vmcnt(3)
  buffer_load_dwordx4 v[96:99], v2, s[12:15], s28 offen nt
  buffer_load_dwordx4 v[100:103], v3, s[12:15], s28 offen nt
  buffer_load_dwordx4 v[104:107], v4, s[12:15], s28 offen nt
  s_add_u32 s28, s28, 3072
  v_mfma_f32_16x16x32_bf16 v[16:19], v[72:75], v[60:63], 0
  v_mfma_f32_16x16x32_bf16 v[16:19], v[76:79], v[64:67], v[16:19]
  v_mfma_f32_16x16x32_bf16 v[16:19], v[80:83], v[68:71], v[16:19]
  s_nop 7
  v_add_f32_dpp v20, v17, v16 row_ror:4 row_mask:0xf bank_mask:0x5
  v_add_f32_dpp v21, v19, v18 row_ror:4 row_mask:0xf bank_mask:0x5
  s_nop 0
  v_add_f32_dpp v20, v16, v17 row_ror:4 row_mask:0xf bank_mask:0xa
  v_add_f32_dpp v21, v18, v19 row_ror:4 row_mask:0xf bank_mask:0xa
  v_max3_f32 v7, v20, v21, v7
  ds_write_b64 v10, v[20:21] offset:0
  s_waitcnt vmcnt(3)
  buffer_load_dwordx4 v[108:111], v2, s[12:15], s28 offen nt
  buffer_load_dwordx4 v[112:115], v3, s[12:15], s28 offen nt
  buffer_load_dwordx4 v[116:119], v4, s[12:15], s28 offen nt
  s_add_u32 s28, s28, 21504
  s_cmp_ge_u32 s28, s31
  s_cselect_b32 s35, 786432, 0
  s_sub_u32 s28, s28, s35
  v_mfma_f32_16x16x32_bf16 v[16:19], v[84:87], v[60:63], 0
  v_mfma_f32_16x16x32_bf16 v[16:19], v[88:91], v[64:67], v[16:19]
  v_mfma_f32_16x16x32_bf16 v[16:19], v[92:95], v[68:71], v[16:19]
  s_nop 7
  v_add_f32_dpp v20, v17, v16 row_ror:4 row_mask:0xf bank_mask:0x5
  v_add_f32_dpp v21, v19, v18 row_ror:4 row_mask:0xf bank_mask:0x5
  s_nop 0
  v_add_f32_dpp v20, v16, v17 row_ror:4 row_mask:0xf bank_mask:0xa
  v_add_f32_dpp v21, v18, v19 row_ror:4 row_mask:0xf bank_mask:0xa
  v_max3_f32 v7, v20, v21, v7
  ds_write_b64 v10, v[20:21] offset:128
  s_waitcnt vmcnt(3)
  s_cmp_lg_u32 s29, 1
  s_cbranch_scc1 L_nosw
  s_mov_b32 s12, s16
  s_mov_b32 s13, s17
  v_mov_b32 v2, v28
  v_mov_b32 v3, v29
  v_mov_b32 v4, v30
L_nosw:
  buffer_load_dwordx4 v[72:75], v2, s[12:15], s28 offen nt
  buffer_load_dwordx4 v[76:79], v3, s[12:15], s28 offen nt
  buffer_load_dwordx4 v[80:83], v4, s[12:15], s28 offen nt
  s_add_u32 s28, s28, 3072
  v_mfma_f32_16x16x32_bf16 v[16:19], v[96:99], v[60:63], 0
  v_mfma_f32_16x16x32_bf16 v[16:19], v[100:103], v[64:67], v[16:19]
  v_mfma_f32_16x16x32_bf16 v[16:19], v[104:107], v[68:71], v[16:19]
  s_nop 7
  v_add_f32_dpp v20, v17, v16 row_ror:4 row_mask:0xf bank_mask:0x5
  v_add_f32_dpp v21, v19, v18 row_ror:4 row_mask:0xf bank_mask:0x5
  s_nop 0
  v_add_f32_dpp v20, v16, v17 row_ror:4 row_mask:0xf bank_mask:0xa
  v_add_f32_dpp v21, v18, v19 row_ror:4 row_mask:0xf bank_mask:0xa
  v_max3_f32 v7, v20, v21, v7
  ds_write_b64 v10, v[20:21] offset:256
  s_waitcnt vmcnt(3)
  buffer_load_dwordx4 v[84:87], v2, s[12:15], s28 offen nt
  buffer_load_dwordx4 v[88:91], v3, s[12:15], s28 offen nt
  buffer_load_dwordx4 v[92:95], v4, s[12:15], s28 offen nt
  s_add_u32 s28, s28, 21504
  s_cmp_ge_u32 s28, s31
  s_cselect_b32 s35, 786432, 0
  s_sub_u32 s28, s28, s35
  v_mfma_f32_16x16x32_bf16 v[16:19], v[108:111], v[60:63], 0
  v_mfma_f32_16x16x32_bf16 v[16:19], v[112:115], v[64:67], v[16:19]
  v_mfma_f32_16x16x32_bf16 v[16:19], v[116:119], v[68:71], v[16:19]
  s_nop 7
  v_add_f32_dpp v20, v17, v16 row_ror:4 row_mask:0xf bank_mask:0x5
  v_add_f32_dpp v21, v19, v18 row_ror:4 row_mask:0xf bank_mask:0x5
  s_nop 0
  v_add_f32_dpp v20, v16, v17 row_ror:4 row_mask:0xf bank_mask:0xa
  v_add_f32_dpp v21, v18, v19 row_ror:4 row_mask:0xf bank_mask:0xa
  v_max3_f32 v7, v20, v21, v7
  ds_write_b64 v10, v[20:21] offset:384
  v_add_u32 v10, 512, v10
  s_sub_u32 s29, s29, 1
  s_cmp_lg_u32 s29, 0
  s_cbranch_scc1 L_loop
  v_mov_b32 v12, v7
  ds_read_b64 v[32:33], v31 offset:0
  ds_read_b64 v[34:35], v31 offset:512
  ds_read_b64 v[36:37], v31 offset:1024
  ds_read_b64 v[38:39], v31 offset:1536
  ds_read_b64 v[40:41], v31 offset:2048
  ds_read_b64 v[42:43], v31 offset:2560
  ds_read_b64 v[44:45], v31 offset:3072
  ds_read_b64 v[46:47], v31 offset:3584
  v_permlane16_swap_b32 v7, v12
  v_max_f32 v7, v7, v12
  v_mov_b32 v12, v7
  v_subrev_u32 v10, 8192, v10
  v_and_b32 v15, 3, v1
  v_permlane32_swap_b32 v7, v12
  v_max_f32 v7, v7, v12
  v_mul_f32 v8, s30, v7
  v_mov_b32 v9, 0
  v_mov_b32 v11, 0
  s_waitcnt lgkmcnt(0)
  ds_read_b64 v[48:49], v31 offset:4096
  ds_read_b64 v[50:51], v31 offset:4608
  ds_read_b64 v[52:53], v31 offset:5120
  ds_read_b64 v[54:55], v31 offset:5632
  ds_read_b64 v[60:61], v31 offset:6144
  ds_read_b64 v[62:63], v31 offset:6656
  ds_read_b64 v[64:65], v31 offset:7168
  ds_read_b64 v[66:67], v31 offset:7680
  v_fma_f32 v32, v32, s30, -v8
  v_fma_f32 v33, v33, s30, -v8
  v_fma_f32 v34, v34, s30, -v8
  v_fma_f32 v35, v35, s30, -v8
  v_fma_f32 v36, v36, s30, -v8
  v_fma_f32 v37, v37, s30, -v8
  v_fma_f32 v38, v38, s30, -v8
  v_fma_f32 v39, v39, s30, -v8
  v_fma_f32 v40, v40, s30, -v8
  v_fma_f32 v41, v41, s30, -v8
  v_fma_f32 v42, v42, s30, -v8
  v_fma_f32 v43, v43, s30, -v8
  v_fma_f32 v44, v44, s30, -v8
  v_fma_f32 v45, v45, s30, -v8
  v_fma_f32 v46, v46, s30, -v8
  v_fma_f32 v47, v47, s30, -v8
  v_exp_f32 v32, v32
  v_exp_f32 v33, v33
  v_exp_f32 v34, v34
  v_exp_f32 v35, v35
  v_exp_f32 v36, v36
  v_exp_f32 v37, v37
  v_exp_f32 v38, v38
  v_exp_f32 v39, v39
  v_exp_f32 v40, v40
  v_exp_f32 v41, v41
  v_exp_f32 v42, v42
  v_exp_f32 v43, v43
  v_exp_f32 v44, v44
  v_exp_f32 v45, v45
  v_exp_f32 v46, v46
  v_exp_f32 v47, v47
  v_add_f32 v9, v9, v32
  v_add_f32 v11, v11, v33
  v_add_f32 v9, v9, v34
  v_add_f32 v11, v11, v35
  v_add_f32 v9, v9, v36
  v_add_f32 v11, v11, v37
  v_add_f32 v9, v9, v38
  v_add_f32 v11, v11, v39
  v_add_f32 v9, v9, v40
  v_add_f32 v11, v11, v41
  v_add_f32 v9, v9, v42
  v_add_f32 v11, v11, v43
  v_add_f32 v9, v9, v44
  v_add_f32 v11, v11, v45
  v_add_f32 v9, v9, v46
  v_add_f32 v11, v11, v47
  s_waitcnt lgkmcnt(0)
  v_fma_f32 v48, v48, s30, -v8
  v_fma_f32 v49, v49, s30, -v8
  v_fma_f32 v50, v50, s30, -v8
  v_fma_f32 v51, v51, s30, -v8
  v_fma_f32 v52, v52, s30, -v8
  v_fma_f32 v53, v53, s30, -v8
  v_fma_f32 v54, v54, s30, -v8
  v_fma_f32 v55, v55, s30, -v8
  v_fma_f32 v60, v60, s30, -v8
  v_fma_f32 v61, v61, s30, -v8
  v_fma_f32 v62, v62, s30, -v8
  v_fma_f32 v63, v63, s30, -v8
  v_fma_f32 v64, v64, s30, -v8
  v_fma_f32 v65, v65, s30, -v8
  v_fma_f32 v66, v66, s30, -v8
  v_fma_f32 v67, v67, s30, -v8
  v_exp_f32 v48, v48
  v_exp_f32 v49, v49
  v_exp_f32 v50, v50
  v_exp_f32 v51, v51
  v_exp_f32 v52, v52
  v_exp_f32 v53, v53
  v_exp_f32 v54, v54
  v_exp_f32 v55, v55
  v_exp_f32 v60, v60
  v_exp_f32 v61, v61
  v_exp_f32 v62, v62
  v_exp_f32 v63, v63
  v_exp_f32 v64, v64
  v_exp_f32 v65, v65
  v_exp_f32 v66, v66
  v_exp_f32 v67, v67
  v_add_f32 v9, v9, v48
  v_add_f32 v11, v11, v49
  v_add_f32 v9, v9, v50
  v_add_f32 v11, v11, v51
  v_add_f32 v9, v9, v52
  v_add_f32 v11, v11, v53
  v_add_f32 v9, v9, v54
  v_add_f32 v11, v11, v55
  v_add_f32 v9, v9, v60
  v_add_f32 v11, v11, v61
  v_add_f32 v9, v9, v62
  v_add_f32 v11, v11, v63
  v_add_f32 v9, v9, v64
  v_add_f32 v11, v11, v65
  v_add_f32 v9, v9, v66
  v_add_f32 v11, v11, v67
  v_add_f32 v9, v9, v11
  s_lshl_b32 s39, s3, 5
  v_lshlrev_b32 v15, 3, v15
  v_add_f32_dpp v9, v9, v9 row_ror:4 row_mask:0xf bank_mask:0xf
  v_add_u32 v15, s39, v15
  v_and_b32 v14, 15, v1
  v_add_f32_dpp v9, v9, v9 row_ror:8 row_mask:0xf bank_mask:0xf
  v_mov_b32 v12, v9
  v_lshlrev_b32 v11, 3, v14
  v_mov_b32 v32, 0
  v_permlane16_swap_b32 v9, v12
  v_add_f32 v9, v9, v12
  v_mov_b32 v12, v9
  v_mov_b32 v33, 0
  v_mov_b32 v34, 0
  v_permlane32_swap_b32 v9, v12
  v_add_f32 v9, v9, v12
  ds_write_b64 v15, v[8:9] offset:12288
  v_mov_b32 v35, 0
  v_mov_b32 v36, 0
  v_mov_b32 v37, 0
  v_mov_b32 v38, 0
  v_mov_b32 v39, 0
  v_mov_b32 v40, 0
  v_mov_b32 v41, 0
  v_mov_b32 v42, 0
  v_mov_b32 v43, 0
  v_mov_b32 v44, 0
  v_mov_b32 v45, 0
  v_mov_b32 v46, 0
  v_mov_b32 v47, 0
  v_mov_b32 v48, 0
  v_mov_b32 v49, 0
  v_mov_b32 v50, 0
  v_mov_b32 v51, 0
  v_mov_b32 v52, 0
  v_mov_b32 v53, 0
  v_mov_b32 v54, 0
  v_mov_b32 v55, 0
  s_waitcnt lgkmcnt(0)
  s_barrier
  ds_read_b64 v[16:17], v11 offset:12288
  ds_read_b64 v[56:57], v10
  v_lshrrev_b32 v15, 4, v1
  v_and_b32 v12, 7, v14
  v_lshrrev_b32 v14, 3, v14
  s_mul_i32 s38, s3, 3072
  v_lshlrev_b32 v12, 4, v12
  v_lshl_add_u32 v60, v15, 8, v12
  v_lshl_add_u32 v60, v14, 10, v60
  v_add_u32 v60, s38, v60
  v_lshlrev_b32 v62, 4, v1
  v_add_u32 v61, s38, v62
  s_lshl_b32 s38, s3, 10
  v_add_u32 v62, s38, v62
  v_mul_u32_u24 v63, 384, v15
  v_add_u32 v63, v63, v12
  v_lshl_add_u32 v63, v14, 3, v63
  s_lshl_b32 s38, s3, 7
  s_add_u32 s33, s33, s38
  s_mov_b32 s29, 16
  s_waitcnt lgkmcnt(0)
  s_nop 1
  v_max_f32_dpp v8, v16, v16 row_ror:4 row_mask:0xf bank_mask:0xf
  s_nop 1
  v_max_f32_dpp v8, v8, v8 row_ror:8 row_mask:0xf bank_mask:0xf
  v_sub_f32 v16, v16, v8
  v_exp_f32 v16, v16
  s_nop 0
  v_mul_f32 v9, v16, v17
  s_nop 1
  v_add_f32_dpp v9, v9, v9 row_ror:4 row_mask:0xf bank_mask:0xf
  s_nop 1
  v_add_f32_dpp v9, v9, v9 row_ror:8 row_mask:0xf bank_mask:0xf
  v_rcp_f32 v9, v9
  ds_read_b64 v[58:59], v10 offset:128
  v_fma_f32 v22, v56, s30, -v8
  v_fma_f32 v23, v57, s30, -v8
  v_exp_f32 v22, v22
  v_exp_f32 v23, v23
  s_nop 0
  v_mul_f32 v22, v22, v9
  v_mul_f32 v23, v23, v9
  v_cvt_pk_bf16_f32 v22, v22, v22
  v_cvt_pk_bf16_f32 v23, v23, v23
  v_and_b32 v24, v22, v5
  v_and_b32 v25, v22, v6
  v_and_b32 v26, v23, v5
  v_and_b32 v27, v23, v6
  s_branch L_loop2
L_last:
  s_waitcnt vmcnt(0)
  s_branch L_skip3
L_loop2:
  s_waitcnt vmcnt(3) lgkmcnt(0)
  buffer_load_dwordx4 v[96:99], v2, s[12:15], s28 offen nt
  buffer_load_dwordx4 v[100:103], v3, s[12:15], s28 offen nt
  buffer_load_dwordx4 v[104:107], v4, s[12:15], s28 offen nt
  s_add_u32 s28, s28, 3072
  ds_read_b64 v[56:57], v10 offset:256
  v_mfma_f32_16x16x16_bf16 v[32:35], v[24:25], v[72:73], v[32:35]
  v_fma_f32 v22, v58, s30, -v8
  v_fma_f32 v23, v59, s30, -v8
  v_mfma_f32_16x16x16_bf16 v[36:39], v[24:25], v[74:75], v[36:39]
  v_exp_f32 v22, v22
  v_exp_f32 v23, v23
  v_mfma_f32_16x16x16_bf16 v[40:43], v[24:25], v[80:81], v[40:43]
  v_mul_f32 v22, v22, v9
  v_mul_f32 v23, v23, v9
  v_mfma_f32_16x16x16_bf16 v[48:51], v[26:27], v[80:81], v[48:51]
  v_cvt_pk_bf16_f32 v22, v22, v22
  v_cvt_pk_bf16_f32 v23, v23, v23
  v_mfma_f32_16x16x16_bf16 v[44:47], v[24:25], v[82:83], v[44:47]
  v_and_b32 v64, v22, v5
  v_and_b32 v65, v22, v6
  v_mfma_f32_16x16x16_bf16 v[52:55], v[26:27], v[82:83], v[52:55]
  v_and_b32 v66, v23, v5
  v_and_b32 v67, v23, v6
  v_mfma_f32_16x16x16_bf16 v[32:35], v[26:27], v[76:77], v[32:35]
  v_mfma_f32_16x16x16_bf16 v[36:39], v[26:27], v[78:79], v[36:39]
  s_waitcnt vmcnt(3) lgkmcnt(0)
  buffer_load_dwordx4 v[108:111], v2, s[12:15], s28 offen nt
  buffer_load_dwordx4 v[112:115], v3, s[12:15], s28 offen nt
  buffer_load_dwordx4 v[116:119], v4, s[12:15], s28 offen nt
  s_add_u32 s28, s28, 21504
  s_cmp_ge_u32 s28, s31
  s_cselect_b32 s35, 786432, 0
  s_sub_u32 s28, s28, s35
  ds_read_b64 v[58:59], v10 offset:384
  v_mfma_f32_16x16x16_bf16 v[32:35], v[64:65], v[84:85], v[32:35]
  v_fma_f32 v22, v56, s30, -v8
  v_fma_f32 v23, v57, s30, -v8
  v_mfma_f32_16x16x16_bf16 v[36:39], v[64:65], v[86:87], v[36:39]
  v_exp_f32 v22, v22
  v_exp_f32 v23, v23
  v_mfma_f32_16x16x16_bf16 v[40:43], v[64:65], v[92:93], v[40:43]
  v_mul_f32 v22, v22, v9
  v_mul_f32 v23, v23, v9
  v_mfma_f32_16x16x16_bf16 v[48:51], v[66:67], v[92:93], v[48:51]
  v_cvt_pk_bf16_f32 v22, v22, v22
  v_cvt_pk_bf16_f32 v23, v23, v23
  v_mfma_f32_16x16x16_bf16 v[44:47], v[64:65], v[94:95], v[44:47]
  v_and_b32 v24, v22, v5
  v_and_b32 v25, v22, v6
  v_mfma_f32_16x16x16_bf16 v[52:55], v[66:67], v[94:95], v[52:55]
  v_and_b32 v26, v23, v5
  v_and_b32 v27, v23, v6
  v_mfma_f32_16x16x16_bf16 v[32:35], v[66:67], v[88:89], v[32:35]
  v_mfma_f32_16x16x16_bf16 v[36:39], v[66:67], v[90:91], v[36:39]
  s_cmp_eq_u32 s29, 1
  s_waitcnt vmcnt(3) lgkmcnt(0)
  s_cbranch_scc1 L_skip2
  buffer_load_dwordx4 v[72:75], v2, s[12:15], s28 offen nt
  buffer_load_dwordx4 v[76:79], v3, s[12:15], s28 offen nt
  buffer_load_dwordx4 v[80:83], v4, s[12:15], s28 offen nt
  s_add_u32 s28, s28, 3072
  ds_read_b64 v[56:57], v10 offset:512
L_skip2:
  v_mfma_f32_16x16x16_bf16 v[32:35], v[24:25], v[96:97], v[32:35]
  v_fma_f32 v22, v58, s30, -v8
  v_fma_f32 v23, v59, s30, -v8
  v_mfma_f32_16x16x16_bf16 v[36:39], v[24:25], v[98:99], v[36:39]
  v_exp_f32 v22, v22
  v_exp_f32 v23, v23
  v_mfma_f32_16x16x16_bf16 v[40:43], v[24:25], v[104:105], v[40:43]
  v_mul_f32 v22, v22, v9
  v_mul_f32 v23, v23, v9
  v_mfma_f32_16x16x16_bf16 v[48:51], v[26:27], v[104:105], v[48:51]
  v_cvt_pk_bf16_f32 v22, v22, v22
  v_cvt_pk_bf16_f32 v23, v23, v23
  v_mfma_f32_16x16x16_bf16 v[44:47], v[24:25], v[106:107], v[44:47]
  v_and_b32 v64, v22, v5
  v_and_b32 v65, v22, v6
  v_mfma_f32_16x16x16_bf16 v[52:55], v[26:27], v[106:107], v[52:55]
  v_and_b32 v66, v23, v5
  v_and_b32 v67, v23, v6
  v_mfma_f32_16x16x16_bf16 v[32:35], v[26:27], v[100:101], v[32:35]
  v_mfma_f32_16x16x16_bf16 v[36:39], v[26:27], v[102:103], v[36:39]
  s_cmp_eq_u32 s29, 1
  s_waitcnt vmcnt(3) lgkmcnt(0)
  s_cbranch_scc1 L_last
  buffer_load_dwordx4 v[84:87], v2, s[12:15], s28 offen nt
  buffer_load_dwordx4 v[88:91], v3, s[12:15], s28 offen nt
  buffer_load_dwordx4 v[92:95], v4, s[12:15], s28 offen nt
  s_add_u32 s28, s28, 21504
  s_cmp_ge_u32 s28, s31
  s_cselect_b32 s35, 786432, 0
  s_sub_u32 s28, s28, s35
  ds_read_b64 v[58:59], v10 offset:640
L_skip3:
  v_mfma_f32_16x16x16_bf16 v[32:35], v[64:65], v[108:109], v[32:35]
  v_fma_f32 v22, v56, s30, -v8
  v_fma_f32 v23, v57, s30, -v8
  v_mfma_f32_16x16x16_bf16 v[36:39], v[64:65], v[110:111], v[36:39]
  v_exp_f32 v22, v22
  v_exp_f32 v23, v23
  v_mfma_f32_16x16x16_bf16 v[40:43], v[64:65], v[116:117], v[40:43]
  v_mul_f32 v22, v22, v9
  v_mul_f32 v23, v23, v9
  v_mfma_f32_16x16x16_bf16 v[48:51], v[66:67], v[116:117], v[48:51]
  v_cvt_pk_bf16_f32 v22, v22, v22
  v_cvt_pk_bf16_f32 v23, v23, v23
  v_mfma_f32_16x16x16_bf16 v[44:47], v[64:65], v[118:119], v[44:47]
  v_and_b32 v24, v22, v5
  v_and_b32 v25, v22, v6
  v_mfma_f32_16x16x16_bf16 v[52:55], v[66:67], v[118:119], v[52:55]
  v_and_b32 v26, v23, v5
  v_and_b32 v27, v23, v6
  v_mfma_f32_16x16x16_bf16 v[32:35], v[66:67], v[112:113], v[32:35]
  v_mfma_f32_16x16x16_bf16 v[36:39], v[66:67], v[114:115], v[36:39]
  v_add_u32 v10, 512, v10
  s_sub_u32 s29, s29, 1
  s_cmp_lg_u32 s29, 0
  s_cbranch_scc1 L_loop2
  v_add_f32_dpp v40, v48, v40 row_ror:8 row_mask:0xf bank_mask:0x3
  v_add_f32_dpp v41, v49, v41 row_ror:8 row_mask:0xf bank_mask:0x3
  v_add_f32_dpp v42, v50, v42 row_ror:8 row_mask:0xf bank_mask:0x3
  v_add_f32_dpp v43, v51, v43 row_ror:8 row_mask:0xf bank_mask:0x3
  v_add_f32_dpp v40, v44, v52 row_ror:8 row_mask:0xf bank_mask:0xc
  v_add_f32_dpp v41, v45, v53 row_ror:8 row_mask:0xf bank_mask:0xc
  v_add_f32_dpp v42, v46, v54 row_ror:8 row_mask:0xf bank_mask:0xc
  v_add_f32_dpp v43, v47, v55 row_ror:8 row_mask:0xf bank_mask:0xc
  ds_write_b128 v60, v[32:35]
  ds_write_b128 v60, v[36:39] offset:128
  ds_write_b128 v61, v[40:43] offset:2048
  s_cmp_ge_u32 s3, 3
  s_waitcnt lgkmcnt(0)
  s_barrier
  s_cbranch_scc1 L_end
  ds_read_b128 v[16:19], v62 offset:0
  ds_read_b128 v[20:23], v62 offset:3072
  ds_read_b128 v[24:27], v62 offset:6144
  ds_read_b128 v[28:31], v62 offset:9216
  s_waitcnt lgkmcnt(2)
  v_add_f32 v16, v16, v20
  v_add_f32 v17, v17, v21
  v_add_f32 v18, v18, v22
  v_add_f32 v19, v19, v23
  s_waitcnt lgkmcnt(1)
  v_add_f32 v16, v16, v24
  v_add_f32 v17, v17, v25
  v_add_f32 v18, v18, v26
  v_add_f32 v19, v19, v27
  s_waitcnt lgkmcnt(0)
  v_add_f32 v16, v16, v28
  v_add_f32 v17, v17, v29
  v_add_f32 v18, v18, v30
  v_add_f32 v19, v19, v31
  s_nop 0
  v_permlane32_swap_b32 v16, v18
  v_permlane32_swap_b32 v17, v19
  s_nop 1
  v_permlane16_swap_b32 v16, v17
  v_permlane16_swap_b32 v18, v19
  v_cvt_pk_bf16_f32 v16, v16, v17
  v_cvt_pk_bf16_f32 v17, v18, v19
  buffer_store_dwordx2 v[16:17], v63, s[24:27], s33 offen
L_end:
s_endpgm
.section .rodata,"a"
.p2align 6
.amdhsa_kernel standalone__mha_softmax__sampling_kernel
  .amdhsa_next_free_vgpr 120
  .amdhsa_next_free_sgpr 40
  .amdhsa_accum_offset 120
  .amdhsa_group_segment_fixed_size 0
  .amdhsa_kernarg_size 48
  .amdhsa_user_sgpr_count 2
  .amdhsa_user_sgpr_kernarg_segment_ptr 1
  .amdhsa_system_sgpr_workgroup_id_x 1
  .amdhsa_float_denorm_mode_32 3
  .amdhsa_float_denorm_mode_16_64 3
.end_amdhsa_kernel
```
